```python
import torch

def _softmax(x, axis=-1):
    return torch.softmax(x, dim=axis)
def _gelu(x):
    return torch.nn.functional.gelu(x, approximate="tanh")
def _silu(x):
    return torch.nn.functional.silu(x)
def _sigmoid(x):
    return torch.sigmoid(x)
def _layernorm(x, axis=-1, eps=1e-5):
    m = x.mean(dim=axis, keepdim=True)
    v = x.var(dim=axis, keepdim=True, unbiased=False)
    return (x - m) / torch.sqrt(v + eps)
def _scatter_add(tgt, idx, src, axis=0):
    return tgt.clone().index_add_(axis, idx, src)
def _segment_sum(src, seg, n):
    out = torch.zeros((n,) + src.shape[1:], dtype=src.dtype)
    return out.index_add_(0, seg, src)
def _pad(x, pw):
    flat = tuple(v for pair in reversed(pw) for v in pair)
    return torch.nn.functional.pad(x, flat)

kernel_name = 'standalone__kv_cache_quant_int4_int2_kv_with_per_channel_or_per_token_scales__decode'

def setup_inputs():

    _w = (lambda a: (lambda t: t.to(torch.bfloat16) if t.is_floating_point() else t)(torch.as_tensor(a)))
    B = 1
    Sq = 1
    Skv = 65536
    Hq = 32
    Hkv = 4
    Dh = 128
    bits = 2
    G = 128
    if G <= 0 or G >= Skv:
        G = max(1, Skv // 2)
    Skv = (Skv // G) * G
    ngk = Skv // G
    qmax = (1 << bits) - 1
    return {
        "q": _w((lambda *s: torch.randn(*s, dtype=torch.bfloat16) * 3.2)(B, Hq, Sq, Dh)),
        "qk": _w(torch.randint(0, qmax + 1, (B, Hkv, Skv, Dh)).to(torch.int32)),
        "qv": _w(torch.randint(0, qmax + 1, (B, Hkv, Skv, Dh)).to(torch.int32)),
        "k_scales": _w(torch.abs((lambda *s: torch.randn(*s, dtype=torch.bfloat16) * 3.2)(B, Hkv, ngk, Dh)) * 0.05 + 0.02),
        "k_zeros": _w((lambda *s: torch.randn(*s, dtype=torch.bfloat16) * 3.2)(B, Hkv, ngk, Dh) + float(qmax) / 2.0),
        "v_scales": _w(torch.abs((lambda *s: torch.randn(*s, dtype=torch.bfloat16) * 0.05)(B, Hkv, Skv, 1)) * 0.05 + 0.02),
        "v_zeros": _w((lambda *s: torch.randn(*s, dtype=torch.bfloat16) * 0.05)(B, Hkv, Skv, 1) + float(qmax) / 2.0),
    }

def reference(q, qk, qv, k_scales, k_zeros, v_scales, v_zeros):
    B, Hq, Sq, Dh = q.shape
    Hkv, Skv = qk.shape[1], qk.shape[2]
    ngk = k_scales.shape[2]
    G = Skv // ngk
    ks = (lambda x, n, axis: torch.repeat_interleave(x, n, dim=axis))(k_scales, G, axis=2)
    kz = (lambda x, n, axis: torch.repeat_interleave(x, n, dim=axis))(k_zeros, G, axis=2)
    k = ((lambda x, dt: x.to(dt))(qk, q.dtype) - kz) * ks
    v = ((lambda x, dt: x.to(dt))(qv, q.dtype) - v_zeros) * v_scales
    rep = Hq // Hkv
    if rep > 1:
        k = (lambda x, n, axis: torch.repeat_interleave(x, n, dim=axis))(k, rep, axis=1)
        v = (lambda x, n, axis: torch.repeat_interleave(x, n, dim=axis))(v, rep, axis=1)
    scale = float(Dh) ** -0.5
    logits = torch.einsum("bhqd,bhkd->bhqk", q, k) * scale
    p = _softmax(logits, axis=-1)
    o = torch.einsum("bhqk,bhkd->bhqd", p, v)
    return o
```

```asm
; @launch grid=(256,1,1) block=(256,1,1) lds=100864
.amdgcn_target "amdgcn-amd-amdhsa--gfx950"
.text
.globl standalone__kv_cache_quant_int4_int2_kv_with_per_channel_or_per_token_scales__decode_kernel
.p2align 8
.type standalone__kv_cache_quant_int4_int2_kv_with_per_channel_or_per_token_scales__decode_kernel,@function
standalone__kv_cache_quant_int4_int2_kv_with_per_channel_or_per_token_scales__decode_kernel:
  s_cmp_ge_u32 s2, 256
  s_cbranch_scc1 L_end
  s_load_dwordx16 s[4:19], s[0:1], 0
  s_load_dwordx4 s[20:23], s[0:1], 64
  v_lshrrev_b32 v7, 6, v0
  v_and_b32 v1, 63, v0
  v_readfirstlane_b32 s3, v7
  v_lshrrev_b32 v2, 4, v1
  v_and_b32 v3, 15, v1
  v_lshlrev_b32 v4, 12, v2
  v_lshl_add_u32 v4, v3, 4, v4
  v_and_b32 v11, 1, v7
  v_lshrrev_b32 v12, 1, v7
  v_lshl_add_u32 v4, v11, 10, v4
  v_lshl_add_u32 v4, v12, 14, v4
  v_and_b32 v31, 1, v2
  v_lshlrev_b32 v31, 11, v31
  v_lshrrev_b32 v10, 1, v2
  v_lshl_add_u32 v31, v10, 14, v31
  v_lshl_add_u32 v31, v3, 4, v31
  s_and_b32 s26, s2, 7
  s_bfe_u32 s25, s2, 0x20003
  s_lshl_b32 s25, s25, 4
  s_add_u32 s26, s26, s25
  s_lshr_b32 s25, s2, 5
  s_lshl_b32 s25, s25, 8
  s_add_u32 s26, s26, s25
  s_lshl_b32 s25, s26, 16
  s_lshl_b32 s26, s26, 8
  s_lshr_b32 s24, s2, 6
  s_lshl_b32 s63, s24, 11
  v_and_b32 v5, 7, v3
  v_lshlrev_b32 v5, 8, v5
  v_lshl_add_u32 v5, v2, 4, v5
  v_add_u32 v5, s63, v5
  v_add_u32 v31, s26, v31
  s_mov_b32 s30, 0xc90000
  s_mov_b32 s31, 0x00020000
  s_mov_b32 s34, 0xc90000
  s_mov_b32 s35, 0x00020000
  s_mov_b32 s59, 0xffff0000
  s_mov_b32 s56, 0
  s_waitcnt lgkmcnt(0)
  s_cmp_eq_u32 s3, 1
  s_cselect_b64 s[40:41], s[12:13], s[10:11]
  s_cmp_eq_u32 s3, 2
  s_cselect_b64 s[40:41], s[14:15], s[40:41]
  s_cmp_eq_u32 s3, 3
  s_cselect_b64 s[40:41], s[16:17], s[40:41]
  v_add_u32 v30, 32768, v31
  global_load_dwordx4 v[68:71], v31, s[40:41] nt
  global_load_dwordx4 v[72:75], v30, s[40:41] nt
  s_add_u32 s28, s6, s25
  s_addc_u32 s29, s7, 0
  buffer_load_dwordx4 v[140:143], v4, s[28:31], 0 offen offset:0 nt
  buffer_load_dwordx4 v[144:147], v4, s[28:31], 0 offen offset:512 nt
  buffer_load_dwordx4 v[148:151], v4, s[28:31], 0 offen offset:256 nt
  buffer_load_dwordx4 v[152:155], v4, s[28:31], 0 offen offset:768 nt
  buffer_load_dwordx4 v[156:159], v4, s[28:31], 0 offen offset:2048 nt
  buffer_load_dwordx4 v[160:163], v4, s[28:31], 0 offen offset:2560 nt
  global_load_dwordx4 v[52:55], v5, s[4:5] offset:0
  global_load_dwordx4 v[56:59], v5, s[4:5] offset:64
  global_load_dwordx4 v[60:63], v5, s[4:5] offset:128
  global_load_dwordx4 v[64:67], v5, s[4:5] offset:192
  s_add_u32 s32, s8, s25
  s_addc_u32 s33, s9, 0
  s_mov_b32 s36, s28
  s_mov_b32 s37, s29
  s_mov_b32 s38, 0xc90000
  s_mov_b32 s39, 0x00020000
  v_lshlrev_b32 v8, 4, v3
  v_add_u32 v8, 18944, v8
  v_lshlrev_b32 v9, 5, v2
  v_lshl_add_u32 v9, v11, 3, v9
  v_lshl_add_u32 v9, v12, 7, v9
  v_add_u32 v9, 27136, v9
  s_mul_i32 s62, s3, 4608
  s_add_u32 s62, s62, 512
  v_mul_u32_u24 v5, 1152, v2
  v_lshl_add_u32 v5, v3, 3, v5
  v_add_u32 v5, s62, v5
  v_mul_u32_u24 v6, 288, v3
  v_lshl_add_u32 v6, v2, 4, v6
  v_add_u32 v6, s62, v6
  s_lshl_b32 s62, s3, 14
  s_add_u32 s62, s62, 35328
  v_lshl_add_u32 v30, v1, 4, s62
  s_lshl_b32 s64, s3, 12
  s_add_u32 s64, s64, 18944
  v_lshl_add_u32 v31, v1, 5, s64
  v_and_b32 v10, 7, v3
  v_lshlrev_b32 v132, 5, v10
  v_lshl_add_u32 v132, v7, 3, v132
  v_lshlrev_b32 v133, 9, v10
  v_lshl_add_u32 v133, v2, 6, v133
  v_and_b32 v10, 8, v3
  v_lshl_add_u32 v133, v10, 5, v133
  v_add_u32 v133, s62, v133
  v_lshrrev_b32 v10, 5, v0
  v_lshlrev_b32 v134, 5, v10
  v_lshlrev_b32 v135, 4, v0
  s_lshl_b32 s64, s2, 12
  v_add_u32 v136, s64, v135
  v_add_u32 v135, 35328, v135
  s_and_b32 s64, s2, 63
  s_lshl_b32 s64, s64, 2
  s_add_u32 s64, s64, s63
  s_add_u32 s64, s64, 1048576
  v_lshlrev_b32 v137, 8, v10
  v_and_b32 v10, 1, v0
  v_lshl_add_u32 v137, v10, 13, v137
  v_add_u32 v137, s64, v137
  v_mov_b32 v138, 256
  v_mov_b32 v100, 0
  v_mov_b32 v101, 0
  v_mov_b32 v102, 0
  v_mov_b32 v103, 0
  v_mov_b32 v104, 0
  v_mov_b32 v105, 0
  v_mov_b32 v106, 0
  v_mov_b32 v107, 0
  v_mov_b32 v108, 0
  v_mov_b32 v109, 0
  v_mov_b32 v110, 0
  v_mov_b32 v111, 0
  v_mov_b32 v112, 0
  v_mov_b32 v113, 0
  v_mov_b32 v114, 0
  v_mov_b32 v115, 0
  v_mov_b32 v116, 0
  v_mov_b32 v117, 0
  v_mov_b32 v118, 0
  v_mov_b32 v119, 0
  v_mov_b32 v120, 0
  v_mov_b32 v121, 0
  v_mov_b32 v122, 0
  v_mov_b32 v123, 0
  v_mov_b32 v124, 0
  v_mov_b32 v125, 0
  v_mov_b32 v126, 0
  v_mov_b32 v127, 0
  v_mov_b32 v128, 0
  v_mov_b32 v129, 0
  v_mov_b32 v130, 0
  v_mov_b32 v131, 0
  v_mov_b32 v15, 0
  v_mov_b32 v14, 0xff7fffff
  s_mov_b32 s60, 0x3db504f3
  s_mov_b32 s61, 0x3fb8aa3b
  s_waitcnt vmcnt(10)
  v_lshlrev_b32 v36, 16, v68
  v_and_b32 v37, s59, v68
  v_lshlrev_b32 v38, 16, v69
  v_and_b32 v39, s59, v69
  v_lshlrev_b32 v40, 16, v70
  v_and_b32 v41, s59, v70
  v_lshlrev_b32 v42, 16, v71
  v_and_b32 v43, s59, v71
  ds_write_b128 v31, v[36:39] offset:0
  ds_write_b128 v31, v[40:43] offset:16
  v_lshlrev_b32 v44, 16, v72
  v_and_b32 v45, s59, v72
  v_lshlrev_b32 v46, 16, v73
  v_and_b32 v47, s59, v73
  v_lshlrev_b32 v48, 16, v74
  v_and_b32 v49, s59, v74
  v_lshlrev_b32 v50, 16, v75
  v_and_b32 v51, s59, v75
  ds_write_b128 v31, v[44:47] offset:2048
  ds_write_b128 v31, v[48:51] offset:2064
  s_waitcnt vmcnt(10) lgkmcnt(0)
  s_barrier
  s_mov_b32 s53, 0
L_kloop:
  ds_read_b128 v[44:47], v8 offset:4096
  ds_read_b128 v[36:39], v8
  ds_read_b128 v[48:51], v8 offset:4352
  ds_read_b128 v[40:43], v8 offset:256
  s_mov_b32 s54, s56
  s_add_u32 s53, s53, 1
  s_and_b32 s56, s53, 1
  s_lshl_b32 s56, s56, 15
  s_and_b32 s64, s53, 2
  s_lshl_b32 s64, s64, 18
  s_or_b32 s56, s56, s64
  s_lshr_b32 s64, s53, 2
  s_lshl_b32 s64, s64, 22
  s_or_b32 s56, s56, s64
  s_and_b32 s64, s56, 0x8000
  s_cselect_b32 s64, 0, 512
  v_add_u32 v8, s64, v8
  s_cmp_lt_u32 s56, 0x1000000
  s_cbranch_scc1 L_knosw
  s_mov_b32 s36, s32
  s_mov_b32 s37, s33
  s_mov_b32 s56, 0
  s_mov_b32 s53, 0
L_knosw:
  s_waitcnt vmcnt(5)
  v_cvt_f32_i32 v16, v140
  v_cvt_f32_i32 v17, v141
  v_cvt_f32_i32 v18, v142
  v_cvt_f32_i32 v19, v143
  buffer_load_dwordx4 v[164:167], v4, s[28:31], s54 offen offset:2304 nt
  s_waitcnt lgkmcnt(0)
  v_pk_add_f32 v[16:17], v[16:17], v[44:45] neg_lo:[0,1] neg_hi:[0,1]
  v_pk_add_f32 v[18:19], v[18:19], v[46:47] neg_lo:[0,1] neg_hi:[0,1]
  v_cvt_pk_bf16_f32 v16, 0, v16
  v_cvt_pk_bf16_f32 v17, 0, v17
  v_cvt_pk_bf16_f32 v18, 0, v18
  v_cvt_pk_bf16_f32 v19, 0, v19
  v_pk_mul_f32 v[16:17], v[16:17], v[36:37]
  v_pk_mul_f32 v[18:19], v[18:19], v[38:39]
  v_cvt_pk_bf16_f32 v10, v16, v17
  v_cvt_pk_bf16_f32 v11, v18, v19
  ds_write_b64 v5, v[10:11] offset:0
  s_waitcnt vmcnt(5)
  v_cvt_f32_i32 v20, v144
  v_cvt_f32_i32 v21, v145
  v_cvt_f32_i32 v22, v146
  v_cvt_f32_i32 v23, v147
  buffer_load_dwordx4 v[168:171], v4, s[28:31], s54 offen offset:2816 nt
  v_pk_add_f32 v[20:21], v[20:21], v[44:45] neg_lo:[0,1] neg_hi:[0,1]
  v_pk_add_f32 v[22:23], v[22:23], v[46:47] neg_lo:[0,1] neg_hi:[0,1]
  v_cvt_pk_bf16_f32 v20, 0, v20
  v_cvt_pk_bf16_f32 v21, 0, v21
  v_cvt_pk_bf16_f32 v22, 0, v22
  v_cvt_pk_bf16_f32 v23, 0, v23
  v_pk_mul_f32 v[20:21], v[20:21], v[36:37]
  v_pk_mul_f32 v[22:23], v[22:23], v[38:39]
  v_cvt_pk_bf16_f32 v12, v20, v21
  v_cvt_pk_bf16_f32 v13, v22, v23
  ds_write_b64 v5, v[12:13] offset:288
  s_waitcnt vmcnt(5)
  v_cvt_f32_i32 v16, v148
  v_cvt_f32_i32 v17, v149
  v_cvt_f32_i32 v18, v150
  v_cvt_f32_i32 v19, v151
  buffer_load_dwordx4 v[140:143], v4, s[36:39], s56 offen offset:0 nt
  v_pk_add_f32 v[16:17], v[16:17], v[48:49] neg_lo:[0,1] neg_hi:[0,1]
  v_pk_add_f32 v[18:19], v[18:19], v[50:51] neg_lo:[0,1] neg_hi:[0,1]
  v_cvt_pk_bf16_f32 v16, 0, v16
  v_cvt_pk_bf16_f32 v17, 0, v17
  v_cvt_pk_bf16_f32 v18, 0, v18
  v_cvt_pk_bf16_f32 v19, 0, v19
  v_pk_mul_f32 v[16:17], v[16:17], v[40:41]
  v_pk_mul_f32 v[18:19], v[18:19], v[42:43]
  v_cvt_pk_bf16_f32 v10, v16, v17
  v_cvt_pk_bf16_f32 v11, v18, v19
  ds_write_b64 v5, v[10:11] offset:128
  s_waitcnt vmcnt(5)
  v_cvt_f32_i32 v20, v152
  v_cvt_f32_i32 v21, v153
  v_cvt_f32_i32 v22, v154
  v_cvt_f32_i32 v23, v155
  buffer_load_dwordx4 v[144:147], v4, s[36:39], s56 offen offset:512 nt
  v_pk_add_f32 v[20:21], v[20:21], v[48:49] neg_lo:[0,1] neg_hi:[0,1]
  v_pk_add_f32 v[22:23], v[22:23], v[50:51] neg_lo:[0,1] neg_hi:[0,1]
  v_cvt_pk_bf16_f32 v20, 0, v20
  v_cvt_pk_bf16_f32 v21, 0, v21
  v_cvt_pk_bf16_f32 v22, 0, v22
  v_cvt_pk_bf16_f32 v23, 0, v23
  v_pk_mul_f32 v[20:21], v[20:21], v[40:41]
  v_pk_mul_f32 v[22:23], v[22:23], v[42:43]
  v_cvt_pk_bf16_f32 v12, v20, v21
  v_cvt_pk_bf16_f32 v13, v22, v23
  ds_write_b64 v5, v[12:13] offset:416
  s_waitcnt vmcnt(5)
  v_cvt_f32_i32 v16, v156
  v_cvt_f32_i32 v17, v157
  v_cvt_f32_i32 v18, v158
  v_cvt_f32_i32 v19, v159
  buffer_load_dwordx4 v[148:151], v4, s[36:39], s56 offen offset:256 nt
  v_pk_add_f32 v[16:17], v[16:17], v[44:45] neg_lo:[0,1] neg_hi:[0,1]
  v_pk_add_f32 v[18:19], v[18:19], v[46:47] neg_lo:[0,1] neg_hi:[0,1]
  v_cvt_pk_bf16_f32 v16, 0, v16
  v_cvt_pk_bf16_f32 v17, 0, v17
  v_cvt_pk_bf16_f32 v18, 0, v18
  v_cvt_pk_bf16_f32 v19, 0, v19
  v_pk_mul_f32 v[16:17], v[16:17], v[36:37]
  v_pk_mul_f32 v[18:19], v[18:19], v[38:39]
  v_cvt_pk_bf16_f32 v10, v16, v17
  v_cvt_pk_bf16_f32 v11, v18, v19
  ds_write_b64 v5, v[10:11] offset:576
  s_waitcnt vmcnt(5)
  v_cvt_f32_i32 v20, v160
  v_cvt_f32_i32 v21, v161
  v_cvt_f32_i32 v22, v162
  v_cvt_f32_i32 v23, v163
  buffer_load_dwordx4 v[152:155], v4, s[36:39], s56 offen offset:768 nt
  v_pk_add_f32 v[20:21], v[20:21], v[44:45] neg_lo:[0,1] neg_hi:[0,1]
  v_pk_add_f32 v[22:23], v[22:23], v[46:47] neg_lo:[0,1] neg_hi:[0,1]
  v_cvt_pk_bf16_f32 v20, 0, v20
  v_cvt_pk_bf16_f32 v21, 0, v21
  v_cvt_pk_bf16_f32 v22, 0, v22
  v_cvt_pk_bf16_f32 v23, 0, v23
  v_pk_mul_f32 v[20:21], v[20:21], v[36:37]
  v_pk_mul_f32 v[22:23], v[22:23], v[38:39]
  v_cvt_pk_bf16_f32 v12, v20, v21
  v_cvt_pk_bf16_f32 v13, v22, v23
  ds_write_b64 v5, v[12:13] offset:864
  ds_read_b128 v[68:71], v6 offset:0
  ds_read_b128 v[72:75], v6 offset:64
  s_waitcnt vmcnt(5)
  v_cvt_f32_i32 v16, v164
  v_cvt_f32_i32 v17, v165
  v_cvt_f32_i32 v18, v166
  v_cvt_f32_i32 v19, v167
  buffer_load_dwordx4 v[156:159], v4, s[36:39], s56 offen offset:2048 nt
  v_pk_add_f32 v[16:17], v[16:17], v[48:49] neg_lo:[0,1] neg_hi:[0,1]
  v_pk_add_f32 v[18:19], v[18:19], v[50:51] neg_lo:[0,1] neg_hi:[0,1]
  v_cvt_pk_bf16_f32 v16, 0, v16
  v_cvt_pk_bf16_f32 v17, 0, v17
  v_cvt_pk_bf16_f32 v18, 0, v18
  v_cvt_pk_bf16_f32 v19, 0, v19
  v_pk_mul_f32 v[16:17], v[16:17], v[40:41]
  v_pk_mul_f32 v[18:19], v[18:19], v[42:43]
  v_cvt_pk_bf16_f32 v10, v16, v17
  v_cvt_pk_bf16_f32 v11, v18, v19
  ds_write_b64 v5, v[10:11] offset:704
  s_waitcnt vmcnt(5)
  v_cvt_f32_i32 v20, v168
  v_cvt_f32_i32 v21, v169
  v_cvt_f32_i32 v22, v170
  v_cvt_f32_i32 v23, v171
  buffer_load_dwordx4 v[160:163], v4, s[36:39], s56 offen offset:2560 nt
  v_pk_add_f32 v[20:21], v[20:21], v[48:49] neg_lo:[0,1] neg_hi:[0,1]
  v_pk_add_f32 v[22:23], v[22:23], v[50:51] neg_lo:[0,1] neg_hi:[0,1]
  v_cvt_pk_bf16_f32 v20, 0, v20
  v_cvt_pk_bf16_f32 v21, 0, v21
  v_cvt_pk_bf16_f32 v22, 0, v22
  v_cvt_pk_bf16_f32 v23, 0, v23
  v_pk_mul_f32 v[20:21], v[20:21], v[40:41]
  v_pk_mul_f32 v[22:23], v[22:23], v[42:43]
  v_cvt_pk_bf16_f32 v12, v20, v21
  v_cvt_pk_bf16_f32 v13, v22, v23
  ds_write_b64 v5, v[12:13] offset:992
  ds_read_b128 v[76:79], v6 offset:128
  ds_read_b128 v[80:83], v6 offset:192
  s_waitcnt lgkmcnt(4)
  v_mfma_f32_16x16x32_bf16 v[24:27], v[68:71], v[52:55], 0
  v_mfma_f32_16x16x32_bf16 v[24:27], v[72:75], v[56:59], v[24:27]
  s_waitcnt lgkmcnt(0)
  v_mfma_f32_16x16x32_bf16 v[24:27], v[76:79], v[60:63], v[24:27]
  v_mfma_f32_16x16x32_bf16 v[24:27], v[80:83], v[64:67], v[24:27]
  s_cmp_lg_u32 s56, 0
  s_nop 6
  v_cvt_pk_bf16_f32 v24, 0, v24
  v_cvt_pk_bf16_f32 v25, 0, v25
  v_cvt_pk_bf16_f32 v26, 0, v26
  v_cvt_pk_bf16_f32 v27, 0, v27
  v_mul_f32 v24, s60, v24
  v_mul_f32 v25, s60, v25
  v_mul_f32 v26, s60, v26
  v_mul_f32 v27, s60, v27
  v_cvt_pk_bf16_f32 v24, 0, v24
  v_cvt_pk_bf16_f32 v25, 0, v25
  v_cvt_pk_bf16_f32 v26, 0, v26
  v_cvt_pk_bf16_f32 v27, 0, v27
  ds_write_b128 v30, v[24:27]
  v_max3_f32 v14, v14, v24, v25
  v_max3_f32 v14, v14, v26, v27
  v_add_u32 v30, 1024, v30
  s_cbranch_scc1 L_kloop
  v_mov_b32 v10, v14
  s_nop 1
  v_permlane16_swap_b32 v14, v10
  v_max_f32 v14, v14, v10
  v_mov_b32 v10, v14
  s_nop 1
  v_permlane32_swap_b32 v14, v10
  v_max_f32 v14, v14, v10
  v_mul_f32 v14, s61, v14
  v_subrev_u32 v30, 16384, v30
L_vloop:
  ds_read_b64 v[40:41], v9 offset:4096
  ds_read_b64 v[42:43], v9 offset:4112
  ds_read_b128 v[24:27], v30
  ds_read_b64 v[36:37], v9
  ds_read_b64 v[38:39], v9 offset:16
  s_mov_b32 s54, s56
  s_add_u32 s53, s53, 1
  s_and_b32 s56, s53, 1
  s_lshl_b32 s56, s56, 15
  s_and_b32 s64, s53, 2
  s_lshl_b32 s64, s64, 18
  s_or_b32 s56, s56, s64
  s_lshr_b32 s64, s53, 2
  s_lshl_b32 s64, s64, 22
  s_or_b32 s56, s56, s64
  v_add_u32 v9, 256, v9
  v_add_u32 v30, 1024, v30
  s_cmp_lt_u32 s56, 0x1000000
  s_waitcnt vmcnt(5)
  v_cvt_f32_i32 v16, v140
  v_cvt_f32_i32 v17, v141
  v_cvt_f32_i32 v18, v142
  v_cvt_f32_i32 v19, v143
  buffer_load_dwordx4 v[164:167], v4, s[32:35], s54 offen offset:2304 nt
  s_waitcnt lgkmcnt(0)
  v_pk_add_f32 v[16:17], v[16:17], v[40:41] op_sel_hi:[1,0] neg_lo:[0,1] neg_hi:[0,1]
  v_pk_add_f32 v[18:19], v[18:19], v[40:41] op_sel_hi:[1,0] neg_lo:[0,1] neg_hi:[0,1]
  v_fma_f32 v24, v24, s61, -v14
  v_fma_f32 v25, v25, s61, -v14
  v_fma_f32 v26, v26, s61, -v14
  v_fma_f32 v27, v27, s61, -v14
  v_exp_f32 v24, v24
  v_exp_f32 v25, v25
  v_exp_f32 v26, v26
  v_exp_f32 v27, v27
  s_waitcnt vmcnt(5)
  v_cvt_f32_i32 v20, v144
  v_cvt_f32_i32 v21, v145
  v_cvt_f32_i32 v22, v146
  v_cvt_f32_i32 v23, v147
  buffer_load_dwordx4 v[168:171], v4, s[32:35], s54 offen offset:2816 nt
  v_pk_add_f32 v[20:21], v[20:21], v[40:41] op_sel:[0,1] op_sel_hi:[1,1] neg_lo:[0,1] neg_hi:[0,1]
  v_pk_add_f32 v[22:23], v[22:23], v[40:41] op_sel:[0,1] op_sel_hi:[1,1] neg_lo:[0,1] neg_hi:[0,1]
  v_cvt_pk_bf16_f32 v84, v16, v20
  v_cvt_pk_bf16_f32 v86, v17, v21
  v_cvt_pk_bf16_f32 v88, v18, v22
  v_cvt_pk_bf16_f32 v90, v19, v23
  v_add_f32 v10, v24, v25
  v_add_f32 v11, v26, v27
  v_pk_mul_f32 v[24:25], v[24:25], v[36:37]
  v_pk_mul_f32 v[26:27], v[26:27], v[38:39]
  v_add_f32 v15, v15, v10
  v_cvt_pk_bf16_f32 v28, v24, v25
  v_cvt_pk_bf16_f32 v29, v26, v27
  v_add_f32 v15, v15, v11
  s_waitcnt vmcnt(5)
  v_cvt_f32_i32 v16, v148
  v_cvt_f32_i32 v17, v149
  v_cvt_f32_i32 v18, v150
  v_cvt_f32_i32 v19, v151
  buffer_load_dwordx4 v[140:143], v4, s[32:35], s56 offen offset:0 nt
  v_pk_add_f32 v[16:17], v[16:17], v[40:41] op_sel_hi:[1,0] neg_lo:[0,1] neg_hi:[0,1]
  v_pk_add_f32 v[18:19], v[18:19], v[40:41] op_sel_hi:[1,0] neg_lo:[0,1] neg_hi:[0,1]
  s_waitcnt vmcnt(5)
  v_cvt_f32_i32 v20, v152
  v_cvt_f32_i32 v21, v153
  v_cvt_f32_i32 v22, v154
  v_cvt_f32_i32 v23, v155
  buffer_load_dwordx4 v[144:147], v4, s[32:35], s56 offen offset:512 nt
  v_pk_add_f32 v[20:21], v[20:21], v[40:41] op_sel:[0,1] op_sel_hi:[1,1] neg_lo:[0,1] neg_hi:[0,1]
  v_pk_add_f32 v[22:23], v[22:23], v[40:41] op_sel:[0,1] op_sel_hi:[1,1] neg_lo:[0,1] neg_hi:[0,1]
  v_cvt_pk_bf16_f32 v92, v16, v20
  v_cvt_pk_bf16_f32 v94, v17, v21
  v_cvt_pk_bf16_f32 v96, v18, v22
  v_cvt_pk_bf16_f32 v98, v19, v23
  s_waitcnt vmcnt(5)
  v_cvt_f32_i32 v16, v156
  v_cvt_f32_i32 v17, v157
  v_cvt_f32_i32 v18, v158
  v_cvt_f32_i32 v19, v159
  buffer_load_dwordx4 v[148:151], v4, s[32:35], s56 offen offset:256 nt
  v_pk_add_f32 v[16:17], v[16:17], v[42:43] op_sel_hi:[1,0] neg_lo:[0,1] neg_hi:[0,1]
  v_pk_add_f32 v[18:19], v[18:19], v[42:43] op_sel_hi:[1,0] neg_lo:[0,1] neg_hi:[0,1]
  s_waitcnt vmcnt(5)
  v_cvt_f32_i32 v20, v160
  v_cvt_f32_i32 v21, v161
  v_cvt_f32_i32 v22, v162
  v_cvt_f32_i32 v23, v163
  buffer_load_dwordx4 v[152:155], v4, s[32:35], s56 offen offset:768 nt
  v_pk_add_f32 v[20:21], v[20:21], v[42:43] op_sel:[0,1] op_sel_hi:[1,1] neg_lo:[0,1] neg_hi:[0,1]
  v_pk_add_f32 v[22:23], v[22:23], v[42:43] op_sel:[0,1] op_sel_hi:[1,1] neg_lo:[0,1] neg_hi:[0,1]
  v_cvt_pk_bf16_f32 v85, v16, v20
  v_cvt_pk_bf16_f32 v87, v17, v21
  v_cvt_pk_bf16_f32 v89, v18, v22
  v_cvt_pk_bf16_f32 v91, v19, v23
  s_nop 0
  v_mfma_f32_16x16x16_bf16 v[100:103], v[84:85], v[28:29], v[100:103]
  v_mfma_f32_16x16x16_bf16 v[104:107], v[86:87], v[28:29], v[104:107]
  v_mfma_f32_16x16x16_bf16 v[108:111], v[88:89], v[28:29], v[108:111]
  v_mfma_f32_16x16x16_bf16 v[112:115], v[90:91], v[28:29], v[112:115]
  s_waitcnt vmcnt(5)
  v_cvt_f32_i32 v16, v164
  v_cvt_f32_i32 v17, v165
  v_cvt_f32_i32 v18, v166
  v_cvt_f32_i32 v19, v167
  buffer_load_dwordx4 v[156:159], v4, s[32:35], s56 offen offset:2048 nt
  v_pk_add_f32 v[16:17], v[16:17], v[42:43] op_sel_hi:[1,0] neg_lo:[0,1] neg_hi:[0,1]
  v_pk_add_f32 v[18:19], v[18:19], v[42:43] op_sel_hi:[1,0] neg_lo:[0,1] neg_hi:[0,1]
  s_waitcnt vmcnt(5)
  v_cvt_f32_i32 v20, v168
  v_cvt_f32_i32 v21, v169
  v_cvt_f32_i32 v22, v170
  v_cvt_f32_i32 v23, v171
  buffer_load_dwordx4 v[160:163], v4, s[32:35], s56 offen offset:2560 nt
  v_pk_add_f32 v[20:21], v[20:21], v[42:43] op_sel:[0,1] op_sel_hi:[1,1] neg_lo:[0,1] neg_hi:[0,1]
  v_pk_add_f32 v[22:23], v[22:23], v[42:43] op_sel:[0,1] op_sel_hi:[1,1] neg_lo:[0,1] neg_hi:[0,1]
  v_cvt_pk_bf16_f32 v93, v16, v20
  v_cvt_pk_bf16_f32 v95, v17, v21
  v_cvt_pk_bf16_f32 v97, v18, v22
  v_cvt_pk_bf16_f32 v99, v19, v23
  s_nop 0
  v_mfma_f32_16x16x16_bf16 v[116:119], v[92:93], v[28:29], v[116:119]
  v_mfma_f32_16x16x16_bf16 v[120:123], v[94:95], v[28:29], v[120:123]
  v_mfma_f32_16x16x16_bf16 v[124:127], v[96:97], v[28:29], v[124:127]
  v_mfma_f32_16x16x16_bf16 v[128:131], v[98:99], v[28:29], v[128:131]
  s_cbranch_scc1 L_vloop
  v_mov_b32 v10, v15
  s_nop 1
  v_permlane16_swap_b32 v15, v10
  v_add_f32 v15, v15, v10
  v_mov_b32 v10, v15
  s_nop 1
  v_permlane32_swap_b32 v15, v10
  v_add_f32 v15, v15, v10
  v_cmp_gt_u32 vcc, 8, v3
  ds_write_b64 v132, v[14:15]
  s_nop 0
  v_cndmask_b32 v68, v116, v100, vcc
  v_cndmask_b32 v69, v120, v104, vcc
  v_cndmask_b32 v70, v124, v108, vcc
  v_cndmask_b32 v71, v128, v112, vcc
  ds_write_b128 v133, v[68:71] offset:0
  v_cndmask_b32 v72, v117, v101, vcc
  v_cndmask_b32 v73, v121, v105, vcc
  v_cndmask_b32 v74, v125, v109, vcc
  v_cndmask_b32 v75, v129, v113, vcc
  ds_write_b128 v133, v[72:75] offset:16
  v_cndmask_b32 v76, v118, v102, vcc
  v_cndmask_b32 v77, v122, v106, vcc
  v_cndmask_b32 v78, v126, v110, vcc
  v_cndmask_b32 v79, v130, v114, vcc
  ds_write_b128 v133, v[76:79] offset:32
  v_cndmask_b32 v80, v119, v103, vcc
  v_cndmask_b32 v81, v123, v107, vcc
  v_cndmask_b32 v82, v127, v111, vcc
  v_cndmask_b32 v83, v131, v115, vcc
  ds_write_b128 v133, v[80:83] offset:48
  s_waitcnt lgkmcnt(0)
  s_barrier
  ds_read_b128 v[16:19], v134
  ds_read_b128 v[20:23], v134 offset:16
  ds_read_b128 v[52:55], v135 offset:0
  ds_read_b128 v[56:59], v135 offset:16384
  ds_read_b128 v[60:63], v135 offset:32768
  ds_read_b128 v[64:67], v135 offset:49152
  v_and_b32 v10, 1, v0
  v_cmp_eq_u32 vcc, 0, v10
  s_waitcnt lgkmcnt(4)
  v_max3_f32 v24, v16, v18, v20
  v_max_f32 v24, v24, v22
  v_sub_f32 v16, v16, v24
  v_sub_f32 v18, v18, v24
  v_sub_f32 v20, v20, v24
  v_sub_f32 v22, v22, v24
  v_exp_f32 v16, v16
  v_exp_f32 v18, v18
  v_exp_f32 v20, v20
  v_exp_f32 v22, v22
  s_waitcnt lgkmcnt(3)
  v_mul_f32 v52, v16, v52
  v_mul_f32 v53, v16, v53
  v_mul_f32 v54, v16, v54
  v_mul_f32 v55, v16, v55
  s_waitcnt lgkmcnt(2)
  v_fmac_f32 v52, v18, v56
  v_fmac_f32 v53, v18, v57
  v_fmac_f32 v54, v18, v58
  v_fmac_f32 v55, v18, v59
  s_waitcnt lgkmcnt(1)
  v_fmac_f32 v52, v20, v60
  v_fmac_f32 v53, v20, v61
  v_fmac_f32 v54, v20, v62
  v_fmac_f32 v55, v20, v63
  s_waitcnt lgkmcnt(0)
  v_fmac_f32 v52, v22, v64
  v_fmac_f32 v53, v22, v65
  v_fmac_f32 v54, v22, v66
  v_fmac_f32 v55, v22, v67
  global_store_dwordx4 v136, v[52:55], s[22:23] sc1
  v_mul_f32 v25, v16, v17
  v_fmac_f32 v25, v18, v19
  v_fmac_f32 v25, v20, v21
  v_fmac_f32 v25, v22, v23
  v_cndmask_b32 v25, v25, v24, vcc
  s_mov_b32 s64, 3
  s_mov_b32 s65, 3
  s_mov_b64 exec, s[64:65]
  global_store_dword v137, v25, s[22:23] sc1
  s_mov_b64 exec, -1
  s_lshl_b32 s64, s24, 6
  v_mov_b32 v10, s64
  v_mov_b32 v11, 1
  v_and_b32 v1, 31, v0
  v_lshrrev_b32 v2, 5, v0
  v_and_b32 v3, 63, v0
  v_lshlrev_b32 v4, 15, v2
  v_lshl_add_u32 v4, v1, 4, v4
  s_lshl_b32 s66, s24, 18
  s_add_u32 s66, s66, 0x1000
  v_add_u32 v4, s66, v4
  v_add_u32 v5, 0x2000, v4
  v_add_u32 v6, 0x4000, v4
  v_add_u32 v7, 0x6000, v4
  s_add_u32 s68, s63, 1048576
  v_lshl_add_u32 v8, v3, 2, s68
  v_lshl_add_u32 v9, v2, 5, s68
  v_add_u32 v14, 8192, v8
  s_waitcnt vmcnt(0)
  s_barrier
  s_cmp_lg_u32 s3, 0
  s_cbranch_scc1 L_wait
  s_mov_b64 exec, 1
  global_atomic_add v12, v10, v11, s[20:21] sc0 sc1
  s_waitcnt vmcnt(0)
  v_readfirstlane_b32 s65, v12
  ds_write_b32 v138, v12
  s_cmp_lt_u32 s65, 56
  s_cbranch_scc1 L_pdone
  s_cmp_eq_u32 s65, 63
  s_cbranch_scc1 L_pdone
L_poll:
  global_load_dword v12, v10, s[20:21] sc1
  s_waitcnt vmcnt(0)
  v_readfirstlane_b32 s66, v12
  s_cmp_ge_u32 s66, 64
  s_cbranch_scc1 L_pdone
  s_sleep 2
  s_branch L_poll
L_pdone:
  s_mov_b64 exec, -1
  s_waitcnt lgkmcnt(0)
L_wait:
  s_barrier
  ds_read_b32 v139, v138
  s_waitcnt lgkmcnt(0)
  v_readfirstlane_b32 s69, v139
  s_cmp_lt_u32 s69, 56
  s_cbranch_scc1 L_fin
  s_sub_u32 s69, s69, 56
  s_lshl_b32 s67, s69, 8
  s_add_u32 s44, s22, s67
  s_addc_u32 s45, s23, 0
  s_add_u32 s46, s44, s67
  s_addc_u32 s47, s45, 0
  global_load_dword v12, v8, s[44:45] sc1
  global_load_dword v13, v14, s[44:45] sc1
  global_load_dwordx4 v[16:19], v9, s[44:45] sc1
  global_load_dwordx4 v[20:23], v9, s[44:45] offset:16 sc1
  global_load_dwordx4 v[24:27], v4, s[46:47] offset:-4096 sc1
  global_load_dwordx4 v[28:31], v4, s[46:47] offset:0 sc1
  global_load_dwordx4 v[32:35], v5, s[46:47] offset:-4096 sc1
  global_load_dwordx4 v[36:39], v5, s[46:47] offset:0 sc1
  global_load_dwordx4 v[40:43], v6, s[46:47] offset:-4096 sc1
  global_load_dwordx4 v[44:47], v6, s[46:47] offset:0 sc1
  global_load_dwordx4 v[48:51], v7, s[46:47] offset:-4096 sc1
  global_load_dwordx4 v[52:55], v7, s[46:47] offset:0 sc1
  s_add_u32 s67, s67, s63
  v_lshlrev_b32 v4, 4, v0
  v_lshlrev_b32 v6, 3, v0
  v_lshl_add_u32 v5, v0, 2, s67
  s_waitcnt vmcnt(10)
  v_mov_b32 v14, v12
  s_nop 1
  v_max_f32_dpp v14, v14, v14 row_ror:8 row_mask:0xf bank_mask:0xf
  s_nop 1
  v_max_f32_dpp v14, v14, v14 row_ror:4 row_mask:0xf bank_mask:0xf
  s_nop 1
  v_max_f32_dpp v14, v14, v14 row_ror:2 row_mask:0xf bank_mask:0xf
  s_nop 1
  v_max_f32_dpp v14, v14, v14 row_ror:1 row_mask:0xf bank_mask:0xf
  v_mov_b32 v15, v14
  s_nop 1
  v_permlane16_swap_b32 v14, v15
  v_max_f32 v14, v14, v15
  v_mov_b32 v15, v14
  s_nop 1
  v_permlane32_swap_b32 v14, v15
  v_max_f32 v14, v14, v15
  v_sub_f32 v12, v12, v14
  s_waitcnt vmcnt(8)
  v_sub_f32 v16, v16, v14
  v_sub_f32 v17, v17, v14
  v_sub_f32 v18, v18, v14
  v_sub_f32 v19, v19, v14
  v_sub_f32 v20, v20, v14
  v_sub_f32 v21, v21, v14
  v_sub_f32 v22, v22, v14
  v_sub_f32 v23, v23, v14
  v_exp_f32 v12, v12
  v_exp_f32 v16, v16
  v_exp_f32 v17, v17
  v_exp_f32 v18, v18
  v_exp_f32 v19, v19
  v_exp_f32 v20, v20
  v_exp_f32 v21, v21
  v_exp_f32 v22, v22
  v_exp_f32 v23, v23
  v_mul_f32 v13, v12, v13
  s_waitcnt vmcnt(7)
  v_mul_f32 v56, v16, v24
  v_mul_f32 v57, v16, v25
  v_mul_f32 v58, v16, v26
  v_mul_f32 v59, v16, v27
  s_waitcnt vmcnt(6)
  v_fmac_f32 v56, v17, v28
  v_fmac_f32 v57, v17, v29
  v_fmac_f32 v58, v17, v30
  v_fmac_f32 v59, v17, v31
  s_waitcnt vmcnt(5)
  v_fmac_f32 v56, v18, v32
  v_fmac_f32 v57, v18, v33
  v_fmac_f32 v58, v18, v34
  v_fmac_f32 v59, v18, v35
  s_waitcnt vmcnt(4)
  v_fmac_f32 v56, v19, v36
  v_fmac_f32 v57, v19, v37
  v_fmac_f32 v58, v19, v38
  v_fmac_f32 v59, v19, v39
  s_waitcnt vmcnt(3)
  v_fmac_f32 v56, v20, v40
  v_fmac_f32 v57, v20, v41
  v_fmac_f32 v58, v20, v42
  v_fmac_f32 v59, v20, v43
  s_waitcnt vmcnt(2)
  v_fmac_f32 v56, v21, v44
  v_fmac_f32 v57, v21, v45
  v_fmac_f32 v58, v21, v46
  v_fmac_f32 v59, v21, v47
  s_waitcnt vmcnt(1)
  v_fmac_f32 v56, v22, v48
  v_fmac_f32 v57, v22, v49
  v_fmac_f32 v58, v22, v50
  v_fmac_f32 v59, v22, v51
  s_waitcnt vmcnt(0)
  v_fmac_f32 v56, v23, v52
  v_fmac_f32 v57, v23, v53
  v_fmac_f32 v58, v23, v54
  v_fmac_f32 v59, v23, v55
  ds_write_b128 v4, v[56:59] offset:512
  s_nop 1
  v_add_f32_dpp v13, v13, v13 row_ror:8 row_mask:0xf bank_mask:0xf
  s_nop 1
  v_add_f32_dpp v13, v13, v13 row_ror:4 row_mask:0xf bank_mask:0xf
  s_nop 1
  v_add_f32_dpp v13, v13, v13 row_ror:2 row_mask:0xf bank_mask:0xf
  s_nop 1
  v_add_f32_dpp v13, v13, v13 row_ror:1 row_mask:0xf bank_mask:0xf
  v_mov_b32 v15, v13
  s_nop 1
  v_permlane16_swap_b32 v13, v15
  v_add_f32 v13, v13, v15
  v_mov_b32 v15, v13
  s_nop 1
  v_permlane32_swap_b32 v13, v15
  v_add_f32 v13, v13, v15
  v_rcp_f32 v13, v13
  s_waitcnt lgkmcnt(0)
  s_barrier
  s_cmp_lg_u32 s3, 0
  s_cbranch_scc1 L_fin
  ds_read_b64 v[16:17], v6 offset:512
  ds_read_b64 v[18:19], v6 offset:1024
  ds_read_b64 v[20:21], v6 offset:1536
  ds_read_b64 v[22:23], v6 offset:2048
  ds_read_b64 v[24:25], v6 offset:2560
  ds_read_b64 v[26:27], v6 offset:3072
  ds_read_b64 v[28:29], v6 offset:3584
  ds_read_b64 v[30:31], v6 offset:4096
  s_waitcnt lgkmcnt(0)
  v_pk_add_f32 v[16:17], v[16:17], v[24:25]
  v_pk_add_f32 v[18:19], v[18:19], v[26:27]
  v_pk_add_f32 v[20:21], v[20:21], v[28:29]
  v_pk_add_f32 v[22:23], v[22:23], v[30:31]
  v_pk_add_f32 v[16:17], v[16:17], v[20:21]
  v_pk_add_f32 v[18:19], v[18:19], v[22:23]
  v_pk_add_f32 v[16:17], v[16:17], v[18:19]
  v_mul_f32 v16, v13, v16
  v_mul_f32 v17, v13, v17
  v_cvt_pk_bf16_f32 v16, v16, v17
  global_store_dword v5, v16, s[18:19]
L_fin:
L_end:
  s_endpgm
.section .rodata,"a"
.p2align 6
.amdhsa_kernel standalone__kv_cache_quant_int4_int2_kv_with_per_channel_or_per_token_scales__decode_kernel
  .amdhsa_next_free_vgpr 172
  .amdhsa_next_free_sgpr 72
  .amdhsa_accum_offset 172
  .amdhsa_group_segment_fixed_size 0
  .amdhsa_kernarg_size 80
  .amdhsa_user_sgpr_count 2
  .amdhsa_user_sgpr_kernarg_segment_ptr 1
  .amdhsa_system_sgpr_workgroup_id_x 1
  .amdhsa_float_denorm_mode_32 3
.end_amdhsa_kernel
```
